```python
import torch

def _softmax(x, axis=-1):
    return torch.softmax(x, dim=axis)
def _gelu(x):
    return torch.nn.functional.gelu(x, approximate="tanh")
def _silu(x):
    return torch.nn.functional.silu(x)
def _sigmoid(x):
    return torch.sigmoid(x)
def _layernorm(x, axis=-1, eps=1e-5):
    m = x.mean(dim=axis, keepdim=True)
    v = x.var(dim=axis, keepdim=True, unbiased=False)
    return (x - m) / torch.sqrt(v + eps)
def _scatter_add(tgt, idx, src, axis=0):
    return tgt.clone().index_add_(axis, idx, src)
def _segment_sum(src, seg, n):
    out = torch.zeros((n,) + src.shape[1:], dtype=src.dtype)
    return out.index_add_(0, seg, src)
def _pad(x, pw):
    flat = tuple(v for pair in reversed(pw) for v in pair)
    return torch.nn.functional.pad(x, flat)

kernel_name = 'concat_heads__gqa_block_cached__sliding_block_cached__decode'

def setup_inputs():

    _w = (lambda a: (lambda t: t.to(torch.bfloat16) if t.is_floating_point() else t)(torch.as_tensor(a)))
    def _A_setup():
        B, Sq, D = 1, 1, 448
        Hq, Hkv, Sk, Dh = 16, 8, 8192, 256
        assert Hq % Hkv == 0, (Hq, Hkv)
        return {
            "x": _w((lambda *s: torch.randn(*s, dtype=torch.bfloat16) * 0.8)(B, Sq, D)),
            "k_cache": _w((lambda *s: torch.randn(*s, dtype=torch.bfloat16) * 1.6)(B, Hkv, Sk, Dh)),
            "v_cache": _w((lambda *s: torch.randn(*s, dtype=torch.bfloat16) * 0.2)(B, Hkv, Sk, Dh)),
            "wq": _w((lambda *s: torch.randn(*s, dtype=torch.bfloat16) * 1.6)(D, Hq * Dh) * (D ** -0.5)),
            "wo": _w((lambda *s: torch.randn(*s, dtype=torch.bfloat16) * 0.2)(Hq * Dh, D) * ((Hq * Dh) ** -0.5)),
        }
    _A_in = _A_setup()

    def _B_setup():
        B, Sq, D = 1, 1, 448
        Hq, Hkv, Sk, Dh = 16, 8, 8192, 256
        assert Hq % Hkv == 0, (Hq, Hkv)
        return {
            "x": _w((lambda *s: torch.randn(*s, dtype=torch.bfloat16) * 0.8)(B, Sq, D)),
            "k_cache": _w((lambda *s: torch.randn(*s, dtype=torch.bfloat16) * 1.6)(B, Hkv, Sk, Dh)),
            "v_cache": _w((lambda *s: torch.randn(*s, dtype=torch.bfloat16) * 0.2)(B, Hkv, Sk, Dh)),
            "wq": _w((lambda *s: torch.randn(*s, dtype=torch.bfloat16) * 1.6)(D, Hq * Dh) * (D ** -0.5)),
            "wo": _w((lambda *s: torch.randn(*s, dtype=torch.bfloat16) * 0.2)(Hq * Dh, D) * ((Hq * Dh) ** -0.5)),
        }
    _B_in = _B_setup()

    return {
        "A_x": _A_in["x"],
        "A_k_cache": _A_in["k_cache"],
        "A_v_cache": _A_in["v_cache"],
        "A_wq": _A_in["wq"],
        "A_wo": _A_in["wo"],
        "B_x": _B_in["x"],
        "B_k_cache": _B_in["k_cache"],
        "B_v_cache": _B_in["v_cache"],
        "B_wq": _B_in["wq"],
        "B_wo": _B_in["wo"],
    }

def reference(A_x, A_k_cache, A_v_cache, A_wq, A_wo, B_x, B_k_cache, B_v_cache, B_wq, B_wo):
    def _A_ref(x, k_cache, v_cache, wq, wo):
        B, Sq, D = x.shape
        Hq, Dh = 16, 256
        Hkv = k_cache.shape[1]
        rep = Hq // Hkv
        q = (lambda x, *d: x.permute(*d))((x @ wq).reshape(B, Sq, Hq, Dh), 0, 2, 1, 3)
        k = (lambda x, n, axis: torch.repeat_interleave(x, n, dim=axis))(k_cache, rep, axis=1)
        v = (lambda x, n, axis: torch.repeat_interleave(x, n, dim=axis))(v_cache, rep, axis=1)
        scores = torch.einsum("bhqd,bhkd->bhqk", q, k) * (Dh ** -0.5)
        p = _softmax(scores, axis=-1)
        o = torch.einsum("bhqk,bhkd->bhqd", p, v)
        return (lambda x, *d: x.permute(*d))(o, 0, 2, 1, 3).reshape(B, Sq, Hq * Dh) @ wo

    def _B_ref(x, k_cache, v_cache, wq, wo):
        B, Sq, D = x.shape
        Hq, Dh = 16, 256
        Hkv, Sk = k_cache.shape[1], k_cache.shape[2]
        W = min(4096, max(256, Sk // 4))
        rep = Hq // Hkv
        q = (lambda x, *d: x.permute(*d))((x @ wq).reshape(B, Sq, Hq, Dh), 0, 2, 1, 3)
        k = (lambda x, n, axis: torch.repeat_interleave(x, n, dim=axis))(k_cache[:, :, Sk - W:, :], rep, axis=1)
        v = (lambda x, n, axis: torch.repeat_interleave(x, n, dim=axis))(v_cache[:, :, Sk - W:, :], rep, axis=1)
        scores = torch.einsum("bhqd,bhkd->bhqk", q, k) * (Dh ** -0.5)
        p = _softmax(scores, axis=-1)
        o = torch.einsum("bhqk,bhkd->bhqd", p, v)
        return (lambda x, *d: x.permute(*d))(o, 0, 2, 1, 3).reshape(B, Sq, Hq * Dh) @ wo

    a = _A_ref(A_x, A_k_cache, A_v_cache, A_wq, A_wo)
    b = _B_ref(B_x, B_k_cache, B_v_cache, B_wq, B_wo)
    return torch.concatenate([a, b], axis=-1)
```

```asm
; @launch grid=(256,1,1) block=(512,1,1) lds=32768
.amdgcn_target "amdgcn-amd-amdhsa--gfx950"
.text
.globl concat_heads__gqa_block_cached__sliding_block_cached__decode_kernel
.p2align 8
.type concat_heads__gqa_block_cached__sliding_block_cached__decode_kernel,@function
concat_heads__gqa_block_cached__sliding_block_cached__decode_kernel:
  s_cmp_ge_u32 s2, 256
  s_cbranch_scc1 L_end
  s_load_dwordx16 s[4:19], s[0:1], 0
  s_load_dwordx8 s[20:27], s[0:1], 64
  s_load_dwordx2 s[28:29], s[0:1], 96
  v_lshrrev_b32 v1, 6, v0
  v_and_b32 v2, 63, v0
  s_and_b32 s31, s2, 7
  v_readfirstlane_b32 s30, v1
  s_lshr_b32 s32, s2, 3
  v_lshrrev_b32 v3, 4, v2
  v_and_b32 v4, 15, v2
  s_and_b32 s33, s30, 3
  s_lshl_b32 s57, s31, 22
  s_lshl_b32 s58, s33, 11
  s_add_u32 s57, s57, s58
  s_mul_i32 s58, s2, 0x9e3779b1
  s_lshr_b32 s58, s58, 7
  s_lshl_b32 s35, s32, 15
  s_add_u32 s35, s35, s57
  s_and_b32 s59, s58, 0x6000
  s_add_u32 s35, s35, s59
  s_add_u32 s35, s35, 0x300000
  s_lshl_b32 s34, s32, 17
  s_add_u32 s34, s34, s57
  s_and_b32 s59, s58, 0x1e000
  s_add_u32 s34, s34, s59
  s_mov_b32 s38, 0x2000000
  s_mov_b32 s39, 0x20000
  s_mov_b32 s42, 0x2000000
  s_mov_b32 s43, 0x20000
  s_mov_b32 s54, 0x10000000
  s_mov_b32 s55, 0x20000
  s_cmp_ge_u32 s30, 4
  s_cbranch_scc1 L_vwave
  s_setprio 1
  v_bfe_u32 v5, v2, 2, 2
  v_and_b32 v6, 3, v2
  v_lshlrev_b32 v7, 6, v3
  v_lshl_add_u32 v7, v6, 4, v7
  v_lshl_add_u32 v7, v5, 9, v7
  s_waitcnt lgkmcnt(0)
  s_mov_b32 s36, s6
  s_mov_b32 s37, s7
  s_mov_b32 s40, s16
  s_mov_b32 s41, s17
  s_xor_b32 s57, s34, 0
  buffer_load_dwordx4 v[96:99], v7, s[36:39], s57 offen offset:0 nt
  buffer_load_dwordx4 v[100:103], v7, s[36:39], s57 offen offset:256 nt
  s_xor_b32 s57, s34, 8192
  buffer_load_dwordx4 v[104:107], v7, s[36:39], s57 offen offset:0 nt
  buffer_load_dwordx4 v[108:111], v7, s[36:39], s57 offen offset:256 nt
  s_load_dword s56, s[28:29], 0
  s_mov_b32 s52, s28
  s_mov_b32 s53, s29
  s_lshl_b32 s61, s31, 5
  s_add_u32 s61, s61, s32
  s_lshl_b32 s61, s61, 12
  s_lshl_b32 s62, s33, 10
  s_add_u32 s61, s61, s62
  s_add_u32 s61, s61, 262144
  v_lshlrev_b32 v8, 4, v2
  buffer_load_dwordx4 v[12:15], v8, s[52:55], s61 offen sc1
  s_barrier
  s_xor_b32 s57, s34, 16384
  buffer_load_dwordx4 v[112:115], v7, s[36:39], s57 offen offset:0 nt
  buffer_load_dwordx4 v[116:119], v7, s[36:39], s57 offen offset:256 nt
  s_xor_b32 s57, s34, 24576
  s_waitcnt vmcnt(5)
  buffer_load_dwordx4 v[120:123], v7, s[36:39], s57 offen offset:0 nt
  s_waitcnt vmcnt(5)
  buffer_load_dwordx4 v[124:127], v7, s[36:39], s57 offen offset:256 nt
  s_xor_b32 s57, s34, 32768
  s_waitcnt vmcnt(5)
  buffer_load_dwordx4 v[128:131], v7, s[36:39], s57 offen offset:0 nt
  s_waitcnt vmcnt(5)
  buffer_load_dwordx4 v[132:135], v7, s[36:39], s57 offen offset:256 nt
  s_xor_b32 s57, s34, 40960
  s_waitcnt vmcnt(5)
  buffer_load_dwordx4 v[136:139], v7, s[36:39], s57 offen offset:0 nt
  s_waitcnt vmcnt(5)
  buffer_load_dwordx4 v[140:143], v7, s[36:39], s57 offen offset:256 nt
  s_xor_b32 s57, s34, 49152
  s_waitcnt vmcnt(5)
  buffer_load_dwordx4 v[144:147], v7, s[36:39], s57 offen offset:0 nt
  s_waitcnt vmcnt(5)
  buffer_load_dwordx4 v[148:151], v7, s[36:39], s57 offen offset:256 nt
  s_xor_b32 s57, s34, 57344
  s_waitcnt vmcnt(5)
  buffer_load_dwordx4 v[152:155], v7, s[36:39], s57 offen offset:0 nt
  s_waitcnt vmcnt(5)
  buffer_load_dwordx4 v[156:159], v7, s[36:39], s57 offen offset:256 nt
  s_xor_b32 s57, s34, 65536
  s_waitcnt vmcnt(5)
  buffer_load_dwordx4 v[160:163], v7, s[36:39], s57 offen offset:0 nt
  s_waitcnt vmcnt(5)
  buffer_load_dwordx4 v[164:167], v7, s[36:39], s57 offen offset:256 nt
  s_xor_b32 s57, s34, 73728
  s_waitcnt vmcnt(5)
  buffer_load_dwordx4 v[168:171], v7, s[36:39], s57 offen offset:0 nt
  s_waitcnt vmcnt(5)
  buffer_load_dwordx4 v[172:175], v7, s[36:39], s57 offen offset:256 nt
  s_xor_b32 s57, s34, 81920
  s_waitcnt vmcnt(5)
  buffer_load_dwordx4 v[176:179], v7, s[36:39], s57 offen offset:0 nt
  s_waitcnt vmcnt(5)
  buffer_load_dwordx4 v[180:183], v7, s[36:39], s57 offen offset:256 nt
  s_xor_b32 s57, s34, 90112
  s_waitcnt vmcnt(5)
  buffer_load_dwordx4 v[184:187], v7, s[36:39], s57 offen offset:0 nt
  s_waitcnt vmcnt(5)
  buffer_load_dwordx4 v[188:191], v7, s[36:39], s57 offen offset:256 nt
  s_xor_b32 s57, s34, 98304
  s_waitcnt vmcnt(5)
  buffer_load_dwordx4 v[192:195], v7, s[36:39], s57 offen offset:0 nt
  s_waitcnt vmcnt(5)
  buffer_load_dwordx4 v[196:199], v7, s[36:39], s57 offen offset:256 nt
  s_xor_b32 s57, s34, 106496
  s_waitcnt vmcnt(5)
  buffer_load_dwordx4 v[200:203], v7, s[36:39], s57 offen offset:0 nt
  s_waitcnt vmcnt(5)
  buffer_load_dwordx4 v[204:207], v7, s[36:39], s57 offen offset:256 nt
  s_xor_b32 s57, s34, 114688
  s_waitcnt vmcnt(5)
  buffer_load_dwordx4 v[208:211], v7, s[36:39], s57 offen offset:0 nt
  s_waitcnt vmcnt(5)
  buffer_load_dwordx4 v[212:215], v7, s[36:39], s57 offen offset:256 nt
  s_xor_b32 s57, s34, 122880
  s_waitcnt vmcnt(5)
  buffer_load_dwordx4 v[216:219], v7, s[36:39], s57 offen offset:0 nt
  s_waitcnt vmcnt(5)
  buffer_load_dwordx4 v[220:223], v7, s[36:39], s57 offen offset:256 nt
  s_xor_b32 s57, s35, 0
  s_waitcnt vmcnt(5)
  buffer_load_dwordx4 v[224:227], v7, s[40:43], s57 offen offset:0 nt
  s_waitcnt vmcnt(5)
  buffer_load_dwordx4 v[228:231], v7, s[40:43], s57 offen offset:256 nt
  s_xor_b32 s57, s35, 8192
  s_waitcnt vmcnt(5)
  buffer_load_dwordx4 v[232:235], v7, s[40:43], s57 offen offset:0 nt
  s_waitcnt vmcnt(5)
  buffer_load_dwordx4 v[236:239], v7, s[40:43], s57 offen offset:256 nt
  s_xor_b32 s57, s35, 16384
  s_waitcnt vmcnt(5)
  buffer_load_dwordx4 v[240:243], v7, s[40:43], s57 offen offset:0 nt
  s_waitcnt vmcnt(5)
  buffer_load_dwordx4 v[244:247], v7, s[40:43], s57 offen offset:256 nt
  s_xor_b32 s57, s35, 24576
  s_waitcnt vmcnt(5)
  buffer_load_dwordx4 v[248:251], v7, s[40:43], s57 offen offset:0 nt
  s_waitcnt vmcnt(5)
  buffer_load_dwordx4 v[252:255], v7, s[40:43], s57 offen offset:256 nt
  s_barrier
  v_bfe_u32 v8, v2, 2, 1
  v_lshlrev_b32 v8, 9, v8
  v_lshl_add_u32 v8, v3, 6, v8
  v_lshl_add_u32 v8, v6, 4, v8
  v_mov_b32 v9, 22616
  v_lshlrev_b32 v12, 4, v2
  s_lshl_b32 s58, s31, 13
  s_lshr_b32 s61, s33, 1
  s_lshl_b32 s61, s61, 12
  s_add_u32 s58, s58, s61
  s_and_b32 s61, s33, 1
  s_lshl_b32 s61, s61, 10
  s_add_u32 s58, s58, s61
  s_add_u32 s58, s58, 65536
  s_lshl_b32 s61, s33, 9
  s_add_u32 s61, s61, 20480
  v_lshl_add_u32 v13, v2, 3, s61
  v_mov_b32 v14, 1
  s_getreg_b32 s68, hwreg(HW_REG_XCC_ID, 0, 4)
  s_waitcnt lgkmcnt(0)
  s_mul_i32 s56, s56, 0x9E3779B1
  s_add_u32 s56, s56, 0x7F4A7C15
  s_mul_i32 s67, s56, 0x85EBCA6B
  s_and_b32 s64, s56, 0x3ff
  s_bfe_u32 s65, s56, 0xa000b
  s_lshr_b32 s66, s56, 22
  s_lshr_b32 s67, s67, 22
  s_mov_b32 s59, 20000
  s_branch L_qpoll1
L_qpoll:
  s_sleep 4
L_qpoll1:
  buffer_load_dwordx4 v[16:19], v12, s[52:55], s58 offen sc1
  buffer_load_dwordx4 v[20:23], v12, s[52:55], s58 offen offset:2048 sc1
  s_waitcnt vmcnt(0)
  v_xor_b32 v10, s64, v16
  v_bitop3_b32 v10, v17, s65, v10 bitop3:0xbe
  v_bitop3_b32 v10, v18, s66, v10 bitop3:0xbe
  v_bitop3_b32 v10, v19, s67, v10 bitop3:0xbe
  v_bitop3_b32 v10, v20, s64, v10 bitop3:0xbe
  v_bitop3_b32 v10, v21, s65, v10 bitop3:0xbe
  v_bitop3_b32 v10, v22, s66, v10 bitop3:0xbe
  v_bitop3_b32 v10, v23, s67, v10 bitop3:0xbe
  v_and_b32 v10, 0xff, v10
  v_cmp_ne_u32 vcc, 0, v10
  s_sub_u32 s59, s59, 1
  s_cbranch_scc1 L_qpoll_done
  s_cbranch_vccnz L_qpoll
L_qpoll_done:
  v_and_b32 v16, 0xffffff00, v16
  v_and_b32 v17, 0xffffff00, v17
  v_and_b32 v18, 0xffffff00, v18
  v_and_b32 v19, 0xffffff00, v19
  v_and_b32 v20, 0xffffff00, v20
  v_and_b32 v21, 0xffffff00, v21
  v_and_b32 v22, 0xffffff00, v22
  v_and_b32 v23, 0xffffff00, v23
  v_add_f32 v16, v16, v20
  v_add_f32 v17, v17, v21
  v_add_f32 v18, v18, v22
  v_add_f32 v19, v19, v23
  v_cvt_pk_bf16_f32 v16, v16, v17
  v_cvt_pk_bf16_f32 v17, v18, v19
  ds_write_b64 v13, v[16:17]
  s_mov_b64 exec, 1
  s_waitcnt lgkmcnt(0)
  ds_add_u32 v9, v14
  s_mov_b64 exec, -1
  s_mov_b32 s59, 2000000
L_qwait:
  ds_read_b32 v10, v9
  s_waitcnt lgkmcnt(0)
  v_readfirstlane_b32 s61, v10
  s_sub_u32 s59, s59, 1
  s_cbranch_scc1 L_qwait_done
  s_cmp_lt_u32 s61, 4
  s_cbranch_scc1 L_qwait
L_qwait_done:
  ds_read_b128 v[16:19], v8 offset:20480
  ds_read_b128 v[20:23], v8 offset:20736
  ds_read_b128 v[24:27], v8 offset:21504
  ds_read_b128 v[28:31], v8 offset:21760
  s_mov_b32 s60, 0x00ff00ff
  s_mov_b32 s61, 0x00ff00ff
  s_mov_b32 s62, 0xff00ff00
  s_mov_b32 s63, 0xff00ff00
  s_waitcnt lgkmcnt(0)
  v_cndmask_b32 v48, 0, v16, s[60:61]
  v_cndmask_b32 v49, 0, v17, s[60:61]
  v_cndmask_b32 v50, 0, v18, s[60:61]
  v_cndmask_b32 v51, 0, v19, s[60:61]
  v_cndmask_b32 v52, 0, v16, s[62:63]
  v_cndmask_b32 v53, 0, v17, s[62:63]
  v_cndmask_b32 v54, 0, v18, s[62:63]
  v_cndmask_b32 v55, 0, v19, s[62:63]
  v_cndmask_b32 v56, 0, v20, s[60:61]
  v_cndmask_b32 v57, 0, v21, s[60:61]
  v_cndmask_b32 v58, 0, v22, s[60:61]
  v_cndmask_b32 v59, 0, v23, s[60:61]
  v_cndmask_b32 v60, 0, v20, s[62:63]
  v_cndmask_b32 v61, 0, v21, s[62:63]
  v_cndmask_b32 v62, 0, v22, s[62:63]
  v_cndmask_b32 v63, 0, v23, s[62:63]
  v_cndmask_b32 v64, 0, v24, s[60:61]
  v_cndmask_b32 v65, 0, v25, s[60:61]
  v_cndmask_b32 v66, 0, v26, s[60:61]
  v_cndmask_b32 v67, 0, v27, s[60:61]
  v_cndmask_b32 v68, 0, v24, s[62:63]
  v_cndmask_b32 v69, 0, v25, s[62:63]
  v_cndmask_b32 v70, 0, v26, s[62:63]
  v_cndmask_b32 v71, 0, v27, s[62:63]
  v_cndmask_b32 v72, 0, v28, s[60:61]
  v_cndmask_b32 v73, 0, v29, s[60:61]
  v_cndmask_b32 v74, 0, v30, s[60:61]
  v_cndmask_b32 v75, 0, v31, s[60:61]
  v_cndmask_b32 v76, 0, v28, s[62:63]
  v_cndmask_b32 v77, 0, v29, s[62:63]
  v_cndmask_b32 v78, 0, v30, s[62:63]
  v_cndmask_b32 v79, 0, v31, s[62:63]
  s_nop 1
  v_mfma_f32_16x16x32_bf16 v[8:11], v[48:51], v[96:99], 0
  v_mfma_f32_16x16x32_bf16 v[8:11], v[56:59], v[100:103], v[8:11]
  v_mfma_f32_16x16x32_bf16 v[8:11], v[52:55], v[104:107], v[8:11]
  v_mfma_f32_16x16x32_bf16 v[8:11], v[60:63], v[108:111], v[8:11]
  v_mfma_f32_16x16x32_bf16 v[12:15], v[48:51], v[112:115], 0
  v_mfma_f32_16x16x32_bf16 v[12:15], v[56:59], v[116:119], v[12:15]
  v_mfma_f32_16x16x32_bf16 v[12:15], v[52:55], v[120:123], v[12:15]
  v_mfma_f32_16x16x32_bf16 v[12:15], v[60:63], v[124:127], v[12:15]
  v_mfma_f32_16x16x32_bf16 v[16:19], v[48:51], v[128:131], 0
  v_mfma_f32_16x16x32_bf16 v[16:19], v[56:59], v[132:135], v[16:19]
  v_mfma_f32_16x16x32_bf16 v[16:19], v[52:55], v[136:139], v[16:19]
  v_mfma_f32_16x16x32_bf16 v[16:19], v[60:63], v[140:143], v[16:19]
  v_mfma_f32_16x16x32_bf16 v[20:23], v[48:51], v[144:147], 0
  v_mfma_f32_16x16x32_bf16 v[20:23], v[56:59], v[148:151], v[20:23]
  v_mfma_f32_16x16x32_bf16 v[20:23], v[52:55], v[152:155], v[20:23]
  v_mfma_f32_16x16x32_bf16 v[20:23], v[60:63], v[156:159], v[20:23]
  v_mfma_f32_16x16x32_bf16 v[24:27], v[48:51], v[160:163], 0
  v_mfma_f32_16x16x32_bf16 v[24:27], v[56:59], v[164:167], v[24:27]
  v_mfma_f32_16x16x32_bf16 v[24:27], v[52:55], v[168:171], v[24:27]
  v_mfma_f32_16x16x32_bf16 v[24:27], v[60:63], v[172:175], v[24:27]
  v_mfma_f32_16x16x32_bf16 v[28:31], v[48:51], v[176:179], 0
  v_mfma_f32_16x16x32_bf16 v[28:31], v[56:59], v[180:183], v[28:31]
  v_mfma_f32_16x16x32_bf16 v[28:31], v[52:55], v[184:187], v[28:31]
  v_mfma_f32_16x16x32_bf16 v[28:31], v[60:63], v[188:191], v[28:31]
  v_mfma_f32_16x16x32_bf16 v[32:35], v[48:51], v[192:195], 0
  v_mfma_f32_16x16x32_bf16 v[32:35], v[56:59], v[196:199], v[32:35]
  v_mfma_f32_16x16x32_bf16 v[32:35], v[52:55], v[200:203], v[32:35]
  v_mfma_f32_16x16x32_bf16 v[32:35], v[60:63], v[204:207], v[32:35]
  v_mfma_f32_16x16x32_bf16 v[36:39], v[48:51], v[208:211], 0
  v_mfma_f32_16x16x32_bf16 v[36:39], v[56:59], v[212:215], v[36:39]
  v_mfma_f32_16x16x32_bf16 v[36:39], v[52:55], v[216:219], v[36:39]
  v_mfma_f32_16x16x32_bf16 v[36:39], v[60:63], v[220:223], v[36:39]
  v_mfma_f32_16x16x32_bf16 v[40:43], v[64:67], v[224:227], 0
  v_mfma_f32_16x16x32_bf16 v[40:43], v[72:75], v[228:231], v[40:43]
  v_mfma_f32_16x16x32_bf16 v[40:43], v[68:71], v[232:235], v[40:43]
  v_mfma_f32_16x16x32_bf16 v[40:43], v[76:79], v[236:239], v[40:43]
  v_mfma_f32_16x16x32_bf16 v[44:47], v[64:67], v[240:243], 0
  v_mfma_f32_16x16x32_bf16 v[44:47], v[72:75], v[244:247], v[44:47]
  v_mfma_f32_16x16x32_bf16 v[44:47], v[68:71], v[248:251], v[44:47]
  v_mfma_f32_16x16x32_bf16 v[44:47], v[76:79], v[252:255], v[44:47]
  s_nop 7
  v_mov_b32_dpp v80, v8 quad_perm:[0,0,0,0] row_mask:0xf bank_mask:0xf
  v_mov_b32_dpp v81, v12 quad_perm:[0,0,0,0] row_mask:0xf bank_mask:0xf
  v_mov_b32_dpp v82, v16 quad_perm:[0,0,0,0] row_mask:0xf bank_mask:0xf
  v_mov_b32_dpp v83, v20 quad_perm:[0,0,0,0] row_mask:0xf bank_mask:0xf
  v_mov_b32_dpp v84, v24 quad_perm:[0,0,0,0] row_mask:0xf bank_mask:0xf
  v_mov_b32_dpp v85, v28 quad_perm:[0,0,0,0] row_mask:0xf bank_mask:0xf
  v_mov_b32_dpp v86, v32 quad_perm:[0,0,0,0] row_mask:0xf bank_mask:0xf
  v_mov_b32_dpp v87, v36 quad_perm:[0,0,0,0] row_mask:0xf bank_mask:0xf
  v_mov_b32_dpp v88, v40 quad_perm:[0,0,0,0] row_mask:0xf bank_mask:0xf
  v_mov_b32_dpp v89, v44 quad_perm:[0,0,0,0] row_mask:0xf bank_mask:0xf
  v_add_f32_dpp v80, v9, v80 quad_perm:[1,1,1,1] row_mask:0xf bank_mask:0xf
  v_add_f32_dpp v81, v13, v81 quad_perm:[1,1,1,1] row_mask:0xf bank_mask:0xf
  v_add_f32_dpp v82, v17, v82 quad_perm:[1,1,1,1] row_mask:0xf bank_mask:0xf
  v_add_f32_dpp v83, v21, v83 quad_perm:[1,1,1,1] row_mask:0xf bank_mask:0xf
  v_add_f32_dpp v84, v25, v84 quad_perm:[1,1,1,1] row_mask:0xf bank_mask:0xf
  v_add_f32_dpp v85, v29, v85 quad_perm:[1,1,1,1] row_mask:0xf bank_mask:0xf
  v_add_f32_dpp v86, v33, v86 quad_perm:[1,1,1,1] row_mask:0xf bank_mask:0xf
  v_add_f32_dpp v87, v37, v87 quad_perm:[1,1,1,1] row_mask:0xf bank_mask:0xf
  v_add_f32_dpp v88, v41, v88 quad_perm:[1,1,1,1] row_mask:0xf bank_mask:0xf
  v_add_f32_dpp v89, v45, v89 quad_perm:[1,1,1,1] row_mask:0xf bank_mask:0xf
  v_add_f32_dpp v80, v10, v80 quad_perm:[2,2,2,2] row_mask:0xf bank_mask:0xf
  v_add_f32_dpp v81, v14, v81 quad_perm:[2,2,2,2] row_mask:0xf bank_mask:0xf
  v_add_f32_dpp v82, v18, v82 quad_perm:[2,2,2,2] row_mask:0xf bank_mask:0xf
  v_add_f32_dpp v83, v22, v83 quad_perm:[2,2,2,2] row_mask:0xf bank_mask:0xf
  v_add_f32_dpp v84, v26, v84 quad_perm:[2,2,2,2] row_mask:0xf bank_mask:0xf
  v_add_f32_dpp v85, v30, v85 quad_perm:[2,2,2,2] row_mask:0xf bank_mask:0xf
  v_add_f32_dpp v86, v34, v86 quad_perm:[2,2,2,2] row_mask:0xf bank_mask:0xf
  v_add_f32_dpp v87, v38, v87 quad_perm:[2,2,2,2] row_mask:0xf bank_mask:0xf
  v_add_f32_dpp v88, v42, v88 quad_perm:[2,2,2,2] row_mask:0xf bank_mask:0xf
  v_add_f32_dpp v89, v46, v89 quad_perm:[2,2,2,2] row_mask:0xf bank_mask:0xf
  v_add_f32_dpp v80, v11, v80 quad_perm:[3,3,3,3] row_mask:0xf bank_mask:0xf
  v_add_f32_dpp v81, v15, v81 quad_perm:[3,3,3,3] row_mask:0xf bank_mask:0xf
  v_add_f32_dpp v82, v19, v82 quad_perm:[3,3,3,3] row_mask:0xf bank_mask:0xf
  v_add_f32_dpp v83, v23, v83 quad_perm:[3,3,3,3] row_mask:0xf bank_mask:0xf
  v_add_f32_dpp v84, v27, v84 quad_perm:[3,3,3,3] row_mask:0xf bank_mask:0xf
  v_add_f32_dpp v85, v31, v85 quad_perm:[3,3,3,3] row_mask:0xf bank_mask:0xf
  v_add_f32_dpp v86, v35, v86 quad_perm:[3,3,3,3] row_mask:0xf bank_mask:0xf
  v_add_f32_dpp v87, v39, v87 quad_perm:[3,3,3,3] row_mask:0xf bank_mask:0xf
  v_add_f32_dpp v88, v43, v88 quad_perm:[3,3,3,3] row_mask:0xf bank_mask:0xf
  v_add_f32_dpp v89, v47, v89 quad_perm:[3,3,3,3] row_mask:0xf bank_mask:0xf
  v_cvt_pk_bf16_f32 v80, v80, v80
  v_cvt_pk_bf16_f32 v81, v81, v81
  v_cvt_pk_bf16_f32 v82, v82, v82
  v_cvt_pk_bf16_f32 v83, v83, v83
  v_cvt_pk_bf16_f32 v84, v84, v84
  v_cvt_pk_bf16_f32 v85, v85, v85
  v_cvt_pk_bf16_f32 v86, v86, v86
  v_cvt_pk_bf16_f32 v87, v87, v87
  v_cvt_pk_bf16_f32 v88, v88, v88
  v_cvt_pk_bf16_f32 v89, v89, v89
  v_and_b32 v80, 0xffff0000, v80
  v_and_b32 v81, 0xffff0000, v81
  v_and_b32 v82, 0xffff0000, v82
  v_and_b32 v83, 0xffff0000, v83
  v_and_b32 v84, 0xffff0000, v84
  v_and_b32 v85, 0xffff0000, v85
  v_and_b32 v86, 0xffff0000, v86
  v_and_b32 v87, 0xffff0000, v87
  v_and_b32 v88, 0xffff0000, v88
  v_and_b32 v89, 0xffff0000, v89
  v_max3_f32 v8, v80, v81, v82
  v_max_f32 v10, v88, v89
  v_max3_f32 v8, v8, v83, v84
  v_max3_f32 v8, v8, v85, v86
  v_max_f32 v8, v8, v87
  s_nop 1
  v_max_f32_dpp v8, v8, v8 row_ror:4 row_mask:0xf bank_mask:0xf
  v_max_f32_dpp v10, v10, v10 row_ror:4 row_mask:0xf bank_mask:0xf
  s_nop 1
  v_max_f32_dpp v8, v8, v8 row_ror:8 row_mask:0xf bank_mask:0xf
  v_max_f32_dpp v10, v10, v10 row_ror:8 row_mask:0xf bank_mask:0xf
  v_mov_b32 v12, v8
  v_mov_b32 v13, v10
  s_nop 1
  v_permlane32_swap_b32 v8, v12
  v_permlane32_swap_b32 v10, v13
  s_nop 0
  v_max_f32 v8, v8, v12
  v_max_f32 v10, v10, v13
  s_mov_b32 s69, 0x3db8aa3b
  v_sub_f32 v80, v80, v8
  v_sub_f32 v81, v81, v8
  v_sub_f32 v82, v82, v8
  v_sub_f32 v83, v83, v8
  v_sub_f32 v84, v84, v8
  v_sub_f32 v85, v85, v8
  v_sub_f32 v86, v86, v8
  v_sub_f32 v87, v87, v8
  v_sub_f32 v88, v88, v10
  v_sub_f32 v89, v89, v10
  v_mul_f32 v80, s69, v80
  v_mul_f32 v81, s69, v81
  v_mul_f32 v82, s69, v82
  v_mul_f32 v83, s69, v83
  v_mul_f32 v84, s69, v84
  v_mul_f32 v85, s69, v85
  v_mul_f32 v86, s69, v86
  v_mul_f32 v87, s69, v87
  v_mul_f32 v88, s69, v88
  v_mul_f32 v89, s69, v89
  v_exp_f32 v80, v80
  v_exp_f32 v81, v81
  v_exp_f32 v82, v82
  v_exp_f32 v83, v83
  v_exp_f32 v84, v84
  v_exp_f32 v85, v85
  v_exp_f32 v86, v86
  v_exp_f32 v87, v87
  v_exp_f32 v88, v88
  v_exp_f32 v89, v89
  s_nop 0
  v_cvt_pk_bf16_f32 v16, v80, v80
  v_cvt_pk_bf16_f32 v17, v81, v81
  v_cvt_pk_bf16_f32 v18, v82, v82
  v_cvt_pk_bf16_f32 v19, v83, v83
  v_cvt_pk_bf16_f32 v20, v84, v84
  v_cvt_pk_bf16_f32 v21, v85, v85
  v_cvt_pk_bf16_f32 v22, v86, v86
  v_cvt_pk_bf16_f32 v23, v87, v87
  v_cvt_pk_bf16_f32 v24, v88, v88
  v_cvt_pk_bf16_f32 v25, v89, v89
  v_bfe_u32 v26, v2, 2, 3
  v_lshrrev_b32 v27, 5, v2
  s_lshl_b32 s61, s33, 10
  s_add_u32 s61, s61, 16384
  v_lshlrev_b32 v28, 2, v27
  v_lshl_add_u32 v28, v26, 3, v28
  v_lshl_add_u32 v29, v28, 3, s61
  v_lshl_add_u32 v30, v28, 1, s61
  s_mov_b32 exec_lo, 0x11111111
  s_mov_b32 exec_hi, 0x11111111
  ds_write_b128 v29, v[16:19]
  ds_write_b128 v29, v[20:23] offset:16
  ds_write_b64 v30, v[24:25] offset:512
  s_mov_b64 exec, -1
  v_add_f32 v9, v80, v81
  v_add_f32 v11, v88, v89
  v_add_f32 v9, v9, v82
  v_add_f32 v9, v9, v83
  v_add_f32 v9, v9, v84
  v_add_f32 v9, v9, v85
  v_add_f32 v9, v9, v86
  v_add_f32 v9, v9, v87
  s_waitcnt lgkmcnt(0)
  s_lshl_b32 s61, s33, 2
  s_add_u32 s61, s61, 22600
  v_mov_b32 v31, s61
  v_mov_b32 v32, 1
  ds_write_b32 v31, v32
  s_nop 1
  v_add_f32_dpp v9, v9, v9 row_ror:4 row_mask:0xf bank_mask:0xf
  v_add_f32_dpp v11, v11, v11 row_ror:4 row_mask:0xf bank_mask:0xf
  s_nop 1
  v_add_f32_dpp v9, v9, v9 row_ror:8 row_mask:0xf bank_mask:0xf
  v_add_f32_dpp v11, v11, v11 row_ror:8 row_mask:0xf bank_mask:0xf
  v_mov_b32 v12, v9
  v_mov_b32 v13, v11
  s_nop 1
  v_permlane32_swap_b32 v9, v12
  v_permlane32_swap_b32 v11, v13
  s_nop 0
  v_add_f32 v9, v9, v12
  v_add_f32 v11, v11, v13
  v_and_b32 v20, 16, v2
  s_lshl_b32 s61, s33, 3
  s_add_u32 s61, s61, 22784
  v_lshl_add_u32 v20, v20, 1, s61
  s_mov_b32 exec_lo, 0x10001
  s_mov_b32 exec_hi, 0x0
  ds_write_b64 v20, v[8:9]
  ds_write_b64 v20, v[10:11] offset:64
  s_mov_b64 exec, 1
  v_mov_b32 v21, 22596
  s_waitcnt lgkmcnt(0)
  ds_add_rtn_u32 v22, v21, v32
  s_waitcnt lgkmcnt(0)
  s_mov_b64 exec, -1
  v_readfirstlane_b32 s61, v22
  s_cmp_lg_u32 s61, 3
  s_cbranch_scc1 L_kjoin
  v_lshlrev_b32 v20, 3, v4
  ds_read_b64 v[8:9], v20 offset:22784
  s_waitcnt lgkmcnt(0)
  v_mov_b32 v10, v8
  s_nop 1
  v_max_f32_dpp v10, v10, v10 quad_perm:[1,0,3,2] row_mask:0xf bank_mask:0xf
  s_nop 1
  v_max_f32_dpp v10, v10, v10 quad_perm:[2,3,0,1] row_mask:0xf bank_mask:0xf
  v_sub_f32 v8, v8, v10
  v_mul_f32 v8, s69, v8
  v_exp_f32 v8, v8
  v_lshlrev_b32 v20, 2, v4
  v_mul_f32 v11, v8, v9
  ds_write_b32 v20, v8 offset:22528
  s_nop 1
  v_add_f32_dpp v11, v11, v11 quad_perm:[1,0,3,2] row_mask:0xf bank_mask:0xf
  s_nop 1
  v_add_f32_dpp v11, v11, v11 quad_perm:[2,3,0,1] row_mask:0xf bank_mask:0xf
  v_mov_b32 v16, v10
  v_mov_b32 v17, s56
  v_and_b32 v18, -16, v11
  v_or_b32 v18, s68, v18
  v_mov_b32 v19, s56
  s_lshl_b32 s57, s31, 11
  s_lshl_b32 s61, s32, 4
  s_add_u32 s61, s61, s57
  s_add_u32 s61, s61, 16384
  v_and_b32 v21, 12, v2
  v_lshlrev_b32 v21, 7, v21
  s_mov_b32 exec_lo, 0x1111
  s_mov_b32 exec_hi, 0x0
  buffer_store_dwordx4 v[16:19], v21, s[52:55], s61 offen sc1
  s_mov_b64 exec, -1
  s_nop 0
L_kjoin:
  v_mov_b32 v16, 0
  v_mov_b32 v17, 0
  v_mov_b32 v18, 0
  v_mov_b32 v19, 0
  s_lshl_b32 s61, s33, 11
  v_lshl_add_u32 v20, v2, 4, s61
  ds_write_b128 v20, v[16:19] offset:24576
  ds_write_b128 v20, v[16:19] offset:25600
  s_lshl_b32 s61, s31, 5
  s_add_u32 s61, s61, s32
  s_lshl_b32 s61, s61, 12
  s_lshl_b32 s62, s33, 5
  s_add_u32 s61, s61, s62
  s_add_u32 s70, s61, 262144
  v_lshrrev_b32 v8, 1, v2
  v_and_b32 v9, 1, v2
  v_lshlrev_b32 v10, 7, v8
  v_lshl_add_u32 v10, v9, 4, v10
  v_subrev_u32 v8, s32, v8
  v_and_b32 v8, 31, v8
  v_lshlrev_b32 v8, 4, v8
  s_lshl_b32 s61, s31, 11
  s_lshr_b32 s62, s32, 3
  s_lshl_b32 s62, s62, 9
  s_add_u32 s61, s61, s62
  s_add_u32 s71, s61, 16384
  v_lshrrev_b32 v11, 5, v2
  v_bfe_u32 v12, v2, 4, 1
  v_lshl_add_u32 v11, v12, 1, v11
  v_lshl_add_u32 v11, v9, 2, v11
  v_lshlrev_b32 v14, 1, v11
  v_lshlrev_b32 v11, 10, v11
  v_bfe_u32 v12, v2, 1, 3
  v_lshl_add_u32 v14, v12, 21, v14
  v_mul_u32_u24 v12, 18, v12
  v_add_u32 v11, v11, v12
  s_lshl_b32 s61, s33, 8
  s_add_u32 s61, s61, 24576
  v_add_u32 v11, s61, v11
  s_and_b32 s61, s32, 28
  s_add_u32 s61, s61, s31
  s_cmp_ge_u32 s31, 4
  s_cselect_b32 s61, 99, s61
  s_and_b32 s62, s32, 3
  s_lshl_b32 s63, s61, 2
  s_add_u32 s63, s63, s62
  s_lshl_b32 s46, s63, 4
  s_lshl_b32 s63, s63, 5
  s_cmp_lg_u32 s30, 0
  s_cselect_b32 s45, 99, s61
  s_cmp_ge_u32 s61, 14
  s_cselect_b32 s62, 522496, 0
  s_add_u32 s63, s63, s62
  s_add_u32 s44, s63, 2097152
  s_add_u32 s40, s44, 131072
  s_add_u32 s41, s44, 262144
  s_add_u32 s42, s44, 393216
  v_bfe_u32 v13, v2, 1, 2
  v_mul_u32_u24 v13, 1920, v13
  v_lshrrev_b32 v15, 3, v2
  v_lshl_add_u32 v13, v15, 14, v13
  v_lshl_add_u32 v13, v9, 4, v13
  s_mov_b32 s48, s24
  s_mov_b32 s49, s25
  s_mov_b32 s50, 1792
  s_mov_b32 s51, 0x20000
  s_lshl_b32 s58, s32, 2
  s_add_u32 s58, s58, s33
  v_mov_b32 v27, s56
  v_mov_b32 v31, 0x3ff
  v_mov_b32 v28, 0
  v_mul_u32_u24 v29, 384, v2
  s_mov_b32 s47, 3145728
  s_mul_i32 s57, s31, 384
  s_add_u32 s57, s57, s47
  s_lshl_b32 s61, s33, 2
  s_add_u32 s61, s61, 22624
  v_mov_b32 v20, s61
  s_mov_b32 s59, 400000
L_twait:
  s_sleep 4
  ds_read_b32 v21, v20
  s_waitcnt lgkmcnt(0)
  v_readfirstlane_b32 s61, v21
  s_sub_u32 s59, s59, 1
  s_cbranch_scc1 L_twait_done
  s_cmp_eq_u32 s61, 0
  s_cbranch_scc1 L_twait
L_twait_done:
  s_mov_b32 s59, 20000
L_wchk:
  buffer_load_dwordx4 v[32:35], v8, s[52:55], s71 offen sc1
  s_waitcnt vmcnt(0)
  v_cmp_ne_u32 vcc, s56, v33
  v_cmp_ne_u32 s[60:61], s56, v35
  s_or_b64 vcc, vcc, s[60:61]
  s_sub_u32 s59, s59, 1
  s_cbranch_scc1 L_wok
  s_cbranch_vccnz L_wchk
L_wok:
  v_and_b32 v25, 15, v34
  v_cmp_ne_u32 vcc, s68, v25
  v_and_b32 v34, -16, v34
  s_cmp_lg_u64 vcc, 0
  s_cselect_b32 s62, 1, 0
  v_mov_b32 v25, 22620
  v_mov_b32 v26, s62
  ds_write_b32 v25, v26
  v_mov_b32 v25, v32
  s_nop 1
  v_max_f32_dpp v25, v25, v25 row_ror:8 row_mask:0xf bank_mask:0xf
  s_nop 1
  v_max_f32_dpp v25, v25, v25 row_ror:4 row_mask:0xf bank_mask:0xf
  s_nop 1
  v_max_f32_dpp v25, v25, v25 row_ror:2 row_mask:0xf bank_mask:0xf
  v_mov_b32 v26, v25
  s_nop 1
  v_permlane16_swap_b32 v25, v26
  s_nop 0
  v_max_f32 v25, v25, v26
  v_mov_b32 v26, v25
  s_nop 1
  v_permlane32_swap_b32 v25, v26
  s_nop 0
  v_max_f32 v25, v25, v26
  v_sub_f32 v24, v32, v25
  v_mul_f32 v24, s69, v24
  v_exp_f32 v24, v24
  s_nop 0
  v_mul_f32 v25, v24, v34
  s_nop 1
  v_add_f32_dpp v25, v25, v25 row_ror:8 row_mask:0xf bank_mask:0xf
  s_nop 1
  v_add_f32_dpp v25, v25, v25 row_ror:4 row_mask:0xf bank_mask:0xf
  s_nop 1
  v_add_f32_dpp v25, v25, v25 row_ror:2 row_mask:0xf bank_mask:0xf
  v_mov_b32 v26, v25
  s_nop 1
  v_permlane16_swap_b32 v25, v26
  s_nop 0
  v_add_f32 v25, v25, v26
  v_mov_b32 v26, v25
  s_nop 1
  v_permlane32_swap_b32 v25, v26
  s_nop 0
  v_add_f32 v25, v25, v26
  v_rcp_f32 v25, v25
  s_nop 0
  v_mul_f32 v24, v24, v25
  s_mov_b32 s59, 20000
  s_waitcnt lgkmcnt(0)
  s_barrier
  s_sleep 11
L_opoll:
  buffer_load_dwordx4 v[16:19], v10, s[52:55], s70 offen sc1
  s_waitcnt vmcnt(0)
  v_xor_b32 v16, s64, v16
  v_xor_b32 v17, s65, v17
  v_xor_b32 v18, s66, v18
  v_xor_b32 v19, s67, v19
  v_or3_b32 v20, v16, v17, v18
  v_bitop3_b32 v20, v20, v19, v31 bitop3:0xa8
  v_cmp_ne_u32 vcc, 0, v20
  s_cbranch_vccnz L_oretry
L_opoll_done:
  s_mov_b64 exec, -1
  s_cmp_eq_u32 s58, 1
  s_cbranch_scc1 L_flag
L_noflag:
  v_pk_mul_f32 v[16:17], v[16:17], v[24:25] op_sel_hi:[1,0]
  v_pk_mul_f32 v[18:19], v[18:19], v[24:25] op_sel_hi:[1,0]
  s_nop 0
  v_permlane32_swap_b32 v16, v17
  v_permlane32_swap_b32 v18, v19
  v_add_f32 v16, v16, v17
  v_add_f32 v18, v18, v19
  s_nop 1
  v_permlane16_swap_b32 v16, v18
  s_nop 0
  v_add_f32 v16, v16, v18
  s_nop 1
  v_add_f32_dpp v16, v16, v16 row_ror:8 row_mask:0xf bank_mask:0xf
  s_nop 1
  v_add_f32_dpp v16, v16, v16 row_ror:4 row_mask:0xf bank_mask:0xf
  s_nop 1
  v_add_f32_dpp v16, v16, v16 row_ror:2 row_mask:0xf bank_mask:0xf
  v_cvt_pk_bf16_f32 v16, v16, v16
  ds_write_b16 v11, v16
  s_waitcnt lgkmcnt(0)
  s_barrier
  s_cmp_ge_u32 s45, 28
  s_cbranch_scc1 L_fin
  s_mov_b32 s59, 20000
  s_mov_b64 exec, 0xff
L_gpoll:
  buffer_load_dword v30, v29, s[52:55], s47 offen sc1
  s_sub_u32 s59, s59, 1
  s_cbranch_scc1 L_gdone
  s_waitcnt vmcnt(0)
  v_cmp_ne_u32 vcc, s56, v30
  s_mov_b64 exec, vcc
  s_cbranch_vccnz L_gpoll
L_gdone:
  s_mov_b64 exec, -1
  s_mov_b32 s59, 20000
  s_sleep 5
L_fpoll:
  buffer_load_dwordx4 v[32:35], v13, s[52:55], s44 offen sc1
  buffer_load_dwordx4 v[36:39], v13, s[52:55], s40 offen sc1
  buffer_load_dwordx4 v[40:43], v13, s[52:55], s41 offen sc1
  buffer_load_dwordx4 v[44:47], v13, s[52:55], s42 offen sc1
  s_waitcnt vmcnt(3)
  v_xor_b32 v32, s64, v32
  v_xor_b32 v33, s65, v33
  v_xor_b32 v34, s66, v34
  v_xor_b32 v35, s67, v35
  v_or3_b32 v20, v32, v33, v34
  v_or_b32 v20, v20, v35
  s_waitcnt vmcnt(2)
  v_xor_b32 v36, s64, v36
  v_xor_b32 v37, s65, v37
  v_xor_b32 v38, s66, v38
  v_xor_b32 v39, s67, v39
  v_or3_b32 v20, v36, v37, v20
  v_or3_b32 v20, v38, v39, v20
  v_pk_add_f32 v[48:49], v[32:33], v[36:37]
  v_pk_add_f32 v[50:51], v[34:35], v[38:39]
  s_waitcnt vmcnt(1)
  v_xor_b32 v40, s64, v40
  v_xor_b32 v41, s65, v41
  v_xor_b32 v42, s66, v42
  v_xor_b32 v43, s67, v43
  v_or3_b32 v20, v40, v41, v20
  v_or3_b32 v20, v42, v43, v20
  v_pk_add_f32 v[48:49], v[48:49], v[40:41]
  v_pk_add_f32 v[50:51], v[50:51], v[42:43]
  s_waitcnt vmcnt(0)
  v_xor_b32 v44, s64, v44
  v_xor_b32 v45, s65, v45
  v_xor_b32 v46, s66, v46
  v_xor_b32 v47, s67, v47
  v_or3_b32 v20, v44, v45, v20
  v_or3_b32 v20, v46, v47, v20
  v_pk_add_f32 v[48:49], v[48:49], v[44:45]
  v_pk_add_f32 v[50:51], v[50:51], v[46:47]
  v_and_b32 v20, 0x3ff, v20
  v_cmp_ne_u32 vcc, 0, v20
  s_cbranch_vccnz L_fretry
L_fpoll_done:
  v_permlane32_swap_b32 v48, v49
  v_permlane32_swap_b32 v50, v51
  v_add_f32 v48, v48, v49
  v_add_f32 v50, v50, v51
  s_nop 1
  v_permlane16_swap_b32 v48, v50
  s_nop 0
  v_add_f32 v48, v48, v50
  s_nop 1
  v_add_f32_dpp v48, v48, v48 row_ror:8 row_mask:0xf bank_mask:0xf
  s_nop 1
  v_add_f32_dpp v48, v48, v48 row_ror:4 row_mask:0xf bank_mask:0xf
  s_nop 1
  v_add_f32_dpp v48, v48, v48 row_ror:2 row_mask:0xf bank_mask:0xf
  v_cvt_pk_bf16_f32 v48, v48, v48
  buffer_store_short v48, v14, s[48:51], s46 offen
  s_cmp_lg_u32 s46, 0
  s_cbranch_scc1 L_fin
  s_mov_b64 exec, 1
  buffer_store_dword v27, v28, s[52:55], 0 offen
  s_branch L_fin
L_flag:
  s_mov_b64 exec, 1
  buffer_store_dword v27, v28, s[52:55], s57 offen sc1
  s_mov_b64 exec, -1
  s_branch L_noflag
L_oretry:
  s_mov_b64 exec, vcc
  s_bcnt1_i32_b64 s61, vcc
  s_cmp_le_u32 s61, 8
  s_cbranch_scc1 L_opoll_ns
  s_sleep 4
L_opoll_ns:
  s_sub_u32 s59, s59, 1
  s_cbranch_scc0 L_opoll
  s_branch L_opoll_done
L_fretry:
  s_sub_u32 s59, s59, 1
  s_cbranch_scc0 L_fpoll
  s_branch L_fpoll_done
L_vwave:
  s_setprio 3
  s_cmp_ge_u32 s32, 3
  s_cbranch_scc1 L_nopf
  s_getpc_b64 s[60:61]
L_pc:
  s_sub_u32 s60, s60, L_pc-concat_heads__gqa_block_cached__sliding_block_cached__decode_kernel
  s_subb_u32 s61, s61, 0
  s_lshl_b32 s62, s32, 2
  s_add_u32 s62, s62, s33
  s_lshl_b32 s62, s62, 10
  v_lshl_add_u32 v8, v2, 4, s62
  v_min_u32 v8, L_end-concat_heads__gqa_block_cached__sliding_block_cached__decode_kernel-12, v8
  global_load_dwordx4 v[252:255], v8, s[60:61]
L_nopf:
  v_mov_b32 v5, 22592
  v_mov_b32 v8, 0
  v_mov_b32 v9, 0
  v_mov_b32 v10, 0
  v_mov_b32 v11, 0
  ds_write_b128 v5, v[8:11]
  ds_write_b128 v5, v[8:11] offset:16
  ds_write_b128 v5, v[8:11] offset:32
  v_lshrrev_b32 v6, 3, v2
  v_and_b32 v7, 7, v2
  v_lshlrev_b32 v12, 13, v6
  v_lshl_add_u32 v12, v7, 4, v12
  v_lshlrev_b32 v13, 1, v6
  s_lshr_b32 s63, s31, 1
  s_lshl_b32 s60, s63, 5
  s_add_u32 s60, s60, s32
  s_sub_u32 s60, s60, 16
  s_mul_i32 s61, s60, 147
  s_lshr_b32 s61, s61, 10
  s_mul_i32 s62, s61, 7
  s_sub_u32 s62, s60, s62
  s_cmp_ge_u32 s62, 3
  s_addc_u32 s62, s62, 0
  s_lshl_b32 s61, s61, 3
  s_add_u32 s70, s61, s62
  s_lshl_b32 s63, s63, 3
  s_mov_b32 s61, 0x9090909
  s_lshr_b32 s61, s61, s63
  s_and_b32 s69, s61, 0xff
  s_lshl_b32 s61, s32, 3
  s_add_u32 s61, s61, 3
  s_cmp_lt_i32 s60, 0
  s_cselect_b32 s70, s61, s70
  s_cselect_b32 s69, 7, s69
  s_sub_u32 s61, 14, s69
  s_bitcmp1_b32 s31, 0
  s_cselect_b32 s71, s69, 0
  s_cselect_b32 s69, s61, s69
  s_lshl_b32 s71, s71, 6
  s_lshl_b32 s61, s33, 4
  s_add_u32 s71, s71, s61
  s_and_b32 s61, s70, 63
  s_lshl_b32 s61, s61, 7
  s_lshl_b32 s62, s71, 12
  s_add_u32 s61, s61, s62
  s_mov_b32 s50, 896
  s_mov_b32 s51, 0x20000
  s_mov_b32 s46, 3670016
  s_mov_b32 s47, 0x20000
  s_waitcnt lgkmcnt(0)
  s_load_dword s56, s[28:29], 0
  s_cmp_ge_u32 s70, 64
  s_cselect_b32 s44, s20, s10
  s_cselect_b32 s45, s21, s11
  s_cselect_b32 s48, s14, s4
  s_cselect_b32 s49, s15, s5
  s_cmp_le_u32 s69, 0
  s_cbranch_scc1 L_wqdone
  buffer_load_dwordx4 v[96:99], v12, s[44:47], s61 offen nt
  buffer_load_ushort v24, v13, s[48:51], s71 offen offset:0
  s_add_u32 s61, s61, 262144
  s_cmp_le_u32 s69, 1
  s_cbranch_scc1 L_wqdone
  buffer_load_dwordx4 v[100:103], v12, s[44:47], s61 offen nt
  buffer_load_ushort v25, v13, s[48:51], s71 offen offset:64
  s_add_u32 s61, s61, 262144
  s_cmp_le_u32 s69, 2
  s_cbranch_scc1 L_wqdone
  buffer_load_dwordx4 v[104:107], v12, s[44:47], s61 offen nt
  buffer_load_ushort v26, v13, s[48:51], s71 offen offset:128
  s_add_u32 s61, s61, 262144
  s_cmp_le_u32 s69, 3
  s_cbranch_scc1 L_wqdone
  buffer_load_dwordx4 v[108:111], v12, s[44:47], s61 offen nt
  buffer_load_ushort v27, v13, s[48:51], s71 offen offset:192
  s_add_u32 s61, s61, 262144
  s_cmp_le_u32 s69, 4
  s_cbranch_scc1 L_wqdone
  buffer_load_dwordx4 v[112:115], v12, s[44:47], s61 offen nt
  buffer_load_ushort v28, v13, s[48:51], s71 offen offset:256
  s_add_u32 s61, s61, 262144
  s_cmp_le_u32 s69, 5
  s_cbranch_scc1 L_wqdone
  buffer_load_dwordx4 v[116:119], v12, s[44:47], s61 offen nt
  buffer_load_ushort v29, v13, s[48:51], s71 offen offset:320
  s_add_u32 s61, s61, 262144
  s_cmp_le_u32 s69, 6
  s_cbranch_scc1 L_wqdone
  buffer_load_dwordx4 v[120:123], v12, s[44:47], s61 offen nt
  buffer_load_ushort v30, v13, s[48:51], s71 offen offset:384
  s_add_u32 s61, s61, 262144
  s_cmp_le_u32 s69, 7
  s_cbranch_scc1 L_wqdone
  buffer_load_dwordx4 v[124:127], v12, s[44:47], s61 offen nt
  buffer_load_ushort v31, v13, s[48:51], s71 offen offset:448
  s_add_u32 s61, s61, 262144
  s_cmp_le_u32 s69, 8
  s_cbranch_scc1 L_wqdone
  buffer_load_dwordx4 v[128:131], v12, s[44:47], s61 offen nt
  buffer_load_ushort v32, v13, s[48:51], s71 offen offset:512
L_wqdone:
  s_barrier
  s_mov_b32 s36, s8
  s_mov_b32 s37, s9
  s_mov_b32 s40, s18
  s_mov_b32 s41, s19
  s_mov_b32 s52, s28
  s_mov_b32 s53, s29
  v_lshlrev_b32 v14, 9, v3
  v_lshl_add_u32 v14, v4, 4, v14
  s_cmp_ge_u32 s32, 16
  s_cselect_b32 s44, s22, s12
  s_cselect_b32 s45, s23, s13
  s_and_b32 s48, s32, 15
  s_lshl_b32 s48, s48, 5
  s_lshl_b32 s62, s31, 9
  s_add_u32 s48, s48, s62
  s_mul_i32 s48, s48, 896
  s_lshl_b32 s62, s33, 8
  s_add_u32 s48, s48, s62
  s_add_u32 s49, s48, 3584
  s_cmp_eq_u32 s33, 3
  s_cselect_b32 s62, 7, 15
  s_cselect_b32 s58, 0x00ff00ff, -1
  v_mul_u32_u24 v15, 7168, v3
  v_lshl_add_u32 v15, v4, 4, v15
  v_cmp_lt_u32 vcc, s62, v4
  v_mov_b32 v8, 0x40000000
  s_nop 0
  v_cndmask_b32 v15, v15, v8, vcc
  s_waitcnt lgkmcnt(0)
  s_mul_i32 s56, s56, 0x9E3779B1
  s_add_u32 s56, s56, 0x7F4A7C15
  s_mul_i32 s67, s56, 0x85EBCA6B
  s_and_b32 s64, s56, 0x3ff
  s_bfe_u32 s65, s56, 0xa000b
  s_lshr_b32 s66, s56, 22
  s_lshr_b32 s67, s67, 22
  v_mov_b32 v16, 0
  v_mov_b32 v17, 0
  v_mov_b32 v18, 0
  v_mov_b32 v19, 0
  v_mov_b32 v20, 0
  v_mov_b32 v21, 0
  v_mov_b32 v22, 0
  v_mov_b32 v23, 0
  s_waitcnt vmcnt(0)
  s_cmp_le_u32 s69, 0
  s_cbranch_scc1 L_fmadone
  v_lshlrev_b32 v24, 16, v24
  v_lshlrev_b32 v8, 16, v96
  v_and_b32 v9, 0xffff0000, v96
  v_fmac_f32 v16, v8, v24
  v_fmac_f32 v17, v9, v24
  v_lshlrev_b32 v8, 16, v97
  v_and_b32 v9, 0xffff0000, v97
  v_fmac_f32 v18, v8, v24
  v_fmac_f32 v19, v9, v24
  v_lshlrev_b32 v8, 16, v98
  v_and_b32 v9, 0xffff0000, v98
  v_fmac_f32 v20, v8, v24
  v_fmac_f32 v21, v9, v24
  v_lshlrev_b32 v8, 16, v99
  v_and_b32 v9, 0xffff0000, v99
  v_fmac_f32 v22, v8, v24
  v_fmac_f32 v23, v9, v24
  s_cmp_le_u32 s69, 1
  s_cbranch_scc1 L_fmadone
  v_lshlrev_b32 v25, 16, v25
  v_lshlrev_b32 v8, 16, v100
  v_and_b32 v9, 0xffff0000, v100
  v_fmac_f32 v16, v8, v25
  v_fmac_f32 v17, v9, v25
  v_lshlrev_b32 v8, 16, v101
  v_and_b32 v9, 0xffff0000, v101
  v_fmac_f32 v18, v8, v25
  v_fmac_f32 v19, v9, v25
  v_lshlrev_b32 v8, 16, v102
  v_and_b32 v9, 0xffff0000, v102
  v_fmac_f32 v20, v8, v25
  v_fmac_f32 v21, v9, v25
  v_lshlrev_b32 v8, 16, v103
  v_and_b32 v9, 0xffff0000, v103
  v_fmac_f32 v22, v8, v25
  v_fmac_f32 v23, v9, v25
  s_cmp_le_u32 s69, 2
  s_cbranch_scc1 L_fmadone
  v_lshlrev_b32 v26, 16, v26
  v_lshlrev_b32 v8, 16, v104
  v_and_b32 v9, 0xffff0000, v104
  v_fmac_f32 v16, v8, v26
  v_fmac_f32 v17, v9, v26
  v_lshlrev_b32 v8, 16, v105
  v_and_b32 v9, 0xffff0000, v105
  v_fmac_f32 v18, v8, v26
  v_fmac_f32 v19, v9, v26
  v_lshlrev_b32 v8, 16, v106
  v_and_b32 v9, 0xffff0000, v106
  v_fmac_f32 v20, v8, v26
  v_fmac_f32 v21, v9, v26
  v_lshlrev_b32 v8, 16, v107
  v_and_b32 v9, 0xffff0000, v107
  v_fmac_f32 v22, v8, v26
  v_fmac_f32 v23, v9, v26
  s_cmp_le_u32 s69, 3
  s_cbranch_scc1 L_fmadone
  v_lshlrev_b32 v27, 16, v27
  v_lshlrev_b32 v8, 16, v108
  v_and_b32 v9, 0xffff0000, v108
  v_fmac_f32 v16, v8, v27
  v_fmac_f32 v17, v9, v27
  v_lshlrev_b32 v8, 16, v109
  v_and_b32 v9, 0xffff0000, v109
  v_fmac_f32 v18, v8, v27
  v_fmac_f32 v19, v9, v27
  v_lshlrev_b32 v8, 16, v110
  v_and_b32 v9, 0xffff0000, v110
  v_fmac_f32 v20, v8, v27
  v_fmac_f32 v21, v9, v27
  v_lshlrev_b32 v8, 16, v111
  v_and_b32 v9, 0xffff0000, v111
  v_fmac_f32 v22, v8, v27
  v_fmac_f32 v23, v9, v27
  s_cmp_le_u32 s69, 4
  s_cbranch_scc1 L_fmadone
  v_lshlrev_b32 v28, 16, v28
  v_lshlrev_b32 v8, 16, v112
  v_and_b32 v9, 0xffff0000, v112
  v_fmac_f32 v16, v8, v28
  v_fmac_f32 v17, v9, v28
  v_lshlrev_b32 v8, 16, v113
  v_and_b32 v9, 0xffff0000, v113
  v_fmac_f32 v18, v8, v28
  v_fmac_f32 v19, v9, v28
  v_lshlrev_b32 v8, 16, v114
  v_and_b32 v9, 0xffff0000, v114
  v_fmac_f32 v20, v8, v28
  v_fmac_f32 v21, v9, v28
  v_lshlrev_b32 v8, 16, v115
  v_and_b32 v9, 0xffff0000, v115
  v_fmac_f32 v22, v8, v28
  v_fmac_f32 v23, v9, v28
  s_cmp_le_u32 s69, 5
  s_cbranch_scc1 L_fmadone
  v_lshlrev_b32 v29, 16, v29
  v_lshlrev_b32 v8, 16, v116
  v_and_b32 v9, 0xffff0000, v116
  v_fmac_f32 v16, v8, v29
  v_fmac_f32 v17, v9, v29
  v_lshlrev_b32 v8, 16, v117
  v_and_b32 v9, 0xffff0000, v117
  v_fmac_f32 v18, v8, v29
  v_fmac_f32 v19, v9, v29
  v_lshlrev_b32 v8, 16, v118
  v_and_b32 v9, 0xffff0000, v118
  v_fmac_f32 v20, v8, v29
  v_fmac_f32 v21, v9, v29
  v_lshlrev_b32 v8, 16, v119
  v_and_b32 v9, 0xffff0000, v119
  v_fmac_f32 v22, v8, v29
  v_fmac_f32 v23, v9, v29
  s_cmp_le_u32 s69, 6
  s_cbranch_scc1 L_fmadone
  v_lshlrev_b32 v30, 16, v30
  v_lshlrev_b32 v8, 16, v120
  v_and_b32 v9, 0xffff0000, v120
  v_fmac_f32 v16, v8, v30
  v_fmac_f32 v17, v9, v30
  v_lshlrev_b32 v8, 16, v121
  v_and_b32 v9, 0xffff0000, v121
  v_fmac_f32 v18, v8, v30
  v_fmac_f32 v19, v9, v30
  v_lshlrev_b32 v8, 16, v122
  v_and_b32 v9, 0xffff0000, v122
  v_fmac_f32 v20, v8, v30
  v_fmac_f32 v21, v9, v30
  v_lshlrev_b32 v8, 16, v123
  v_and_b32 v9, 0xffff0000, v123
  v_fmac_f32 v22, v8, v30
  v_fmac_f32 v23, v9, v30
  s_cmp_le_u32 s69, 7
  s_cbranch_scc1 L_fmadone
  v_lshlrev_b32 v31, 16, v31
  v_lshlrev_b32 v8, 16, v124
  v_and_b32 v9, 0xffff0000, v124
  v_fmac_f32 v16, v8, v31
  v_fmac_f32 v17, v9, v31
  v_lshlrev_b32 v8, 16, v125
  v_and_b32 v9, 0xffff0000, v125
  v_fmac_f32 v18, v8, v31
  v_fmac_f32 v19, v9, v31
  v_lshlrev_b32 v8, 16, v126
  v_and_b32 v9, 0xffff0000, v126
  v_fmac_f32 v20, v8, v31
  v_fmac_f32 v21, v9, v31
  v_lshlrev_b32 v8, 16, v127
  v_and_b32 v9, 0xffff0000, v127
  v_fmac_f32 v22, v8, v31
  v_fmac_f32 v23, v9, v31
  s_cmp_le_u32 s69, 8
  s_cbranch_scc1 L_fmadone
  v_lshlrev_b32 v32, 16, v32
  v_lshlrev_b32 v8, 16, v128
  v_and_b32 v9, 0xffff0000, v128
  v_fmac_f32 v16, v8, v32
  v_fmac_f32 v17, v9, v32
  v_lshlrev_b32 v8, 16, v129
  v_and_b32 v9, 0xffff0000, v129
  v_fmac_f32 v18, v8, v32
  v_fmac_f32 v19, v9, v32
  v_lshlrev_b32 v8, 16, v130
  v_and_b32 v9, 0xffff0000, v130
  v_fmac_f32 v20, v8, v32
  v_fmac_f32 v21, v9, v32
  v_lshlrev_b32 v8, 16, v131
  v_and_b32 v9, 0xffff0000, v131
  v_fmac_f32 v22, v8, v32
  v_fmac_f32 v23, v9, v32
L_fmadone:
  s_nop 1
  v_add_f32_dpp v16, v16, v16 row_ror:8 row_mask:0xf bank_mask:0xf
  v_add_f32_dpp v17, v17, v17 row_ror:8 row_mask:0xf bank_mask:0xf
  v_add_f32_dpp v18, v18, v18 row_ror:8 row_mask:0xf bank_mask:0xf
  v_add_f32_dpp v19, v19, v19 row_ror:8 row_mask:0xf bank_mask:0xf
  v_add_f32_dpp v20, v20, v20 row_ror:8 row_mask:0xf bank_mask:0xf
  v_add_f32_dpp v21, v21, v21 row_ror:8 row_mask:0xf bank_mask:0xf
  v_add_f32_dpp v22, v22, v22 row_ror:8 row_mask:0xf bank_mask:0xf
  v_add_f32_dpp v23, v23, v23 row_ror:8 row_mask:0xf bank_mask:0xf
  s_lshl_b32 s61, s33, 10
  s_add_u32 s61, s61, 0
  v_lshlrev_b32 v8, 8, v3
  v_lshl_add_u32 v8, v7, 5, v8
  v_add_u32 v8, s61, v8
  s_mov_b32 exec_lo, 0xff00ff
  s_mov_b32 exec_hi, 0xff00ff
  ds_write_b128 v8, v[16:19]
  ds_write_b128 v8, v[20:23] offset:16
  s_mov_b64 exec, 1
  v_mov_b32 v9, 1
  s_waitcnt lgkmcnt(0)
  ds_add_rtn_u32 v10, v5, v9
  s_waitcnt lgkmcnt(0)
  s_mov_b64 exec, -1
  v_readfirstlane_b32 s61, v10
  s_cmp_lg_u32 s61, 3
  s_cbranch_scc1 L_vload
  v_lshlrev_b32 v8, 10, v3
  v_lshl_add_u32 v8, v4, 4, v8
  ds_read_b128 v[16:19], v8 offset:0
  ds_read_b128 v[20:23], v8 offset:256
  ds_read_b128 v[24:27], v8 offset:512
  ds_read_b128 v[28:31], v8 offset:768
  s_waitcnt lgkmcnt(0)
  v_add_f32 v16, v16, v20
  v_add_f32 v24, v24, v28
  v_add_f32 v17, v17, v21
  v_add_f32 v25, v25, v29
  v_add_f32 v18, v18, v22
  v_add_f32 v26, v26, v30
  v_add_f32 v19, v19, v23
  v_add_f32 v27, v27, v31
  v_add_f32 v16, v16, v24
  v_add_f32 v17, v17, v25
  v_add_f32 v18, v18, v26
  v_add_f32 v19, v19, v27
  v_mov_b32 v20, v16
  v_mov_b32 v21, v17
  v_mov_b32 v22, v18
  v_mov_b32 v23, v19
  s_nop 1
  v_permlane16_swap_b32 v16, v20
  v_permlane16_swap_b32 v17, v21
  v_permlane16_swap_b32 v18, v22
  v_permlane16_swap_b32 v19, v23
  s_nop 0
  v_add_f32 v16, v16, v20
  v_add_f32 v17, v17, v21
  v_add_f32 v18, v18, v22
  v_add_f32 v19, v19, v23
  v_mov_b32 v20, v16
  v_mov_b32 v21, v17
  v_mov_b32 v22, v18
  v_mov_b32 v23, v19
  s_nop 1
  v_permlane32_swap_b32 v16, v20
  v_permlane32_swap_b32 v17, v21
  v_permlane32_swap_b32 v18, v22
  v_permlane32_swap_b32 v19, v23
  s_nop 0
  v_add_f32 v16, v16, v20
  v_add_f32 v17, v17, v21
  v_add_f32 v18, v18, v22
  v_add_f32 v19, v19, v23
  s_bfe_u32 s61, s70, 0x30003
  s_lshl_b32 s61, s61, 13
  s_lshr_b32 s62, s70, 6
  s_lshl_b32 s62, s62, 12
  s_add_u32 s61, s61, s62
  s_and_b32 s62, s70, 7
  s_lshl_b32 s62, s62, 8
  s_add_u32 s61, s61, s62
  s_and_b32 s62, s31, 1
  s_lshl_b32 s62, s62, 11
  s_add_u32 s61, s61, s62
  s_add_u32 s61, s61, 65536
  v_lshlrev_b32 v8, 4, v4
  v_mov_b32 v9, 0xff
  v_bfi_b32 v16, v9, s64, v16
  v_bfi_b32 v17, v9, s65, v17
  v_bfi_b32 v18, v9, s66, v18
  v_bfi_b32 v19, v9, s67, v19
  s_mov_b32 exec_lo, 0xffff
  s_mov_b32 exec_hi, 0x0
  buffer_store_dwordx4 v[16:19], v8, s[52:55], s61 offen sc1
  s_mov_b64 exec, -1
L_vload:
  s_setprio 1
  v_and_b32 v12, 1, v2
  v_lshlrev_b32 v12, 4, v12
  v_mov_b32 v13, 0xffff
  v_lshlrev_b32 v12, v12, v13
  v_bfe_u32 v13, v2, 1, 2
  v_cmp_eq_u32 vcc, 0, v13
  s_nop 1
  v_cndmask_b32 v8, 0, v12, vcc
  v_cmp_eq_u32 vcc, 1, v13
  s_nop 1
  v_cndmask_b32 v9, 0, v12, vcc
  v_cmp_eq_u32 vcc, 2, v13
  s_nop 1
  v_cndmask_b32 v10, 0, v12, vcc
  v_cmp_eq_u32 vcc, 3, v13
  s_nop 1
  v_cndmask_b32 v11, 0, v12, vcc
  s_lshl_b32 s61, s33, 12
  v_lshl_add_u32 v92, v2, 4, s61
  s_lshl_b32 s61, s33, 10
  v_lshl_add_u32 v93, v2, 4, s61
  s_lshr_b32 s61, s33, 1
  s_lshl_b32 s62, s61, 5
  s_add_u32 s62, s62, 22528
  v_lshrrev_b32 v12, 5, v2
  v_lshl_add_u32 v94, v12, 4, s62
  s_lshl_b32 s61, s61, 4
  s_and_b32 s62, s33, 1
  s_lshl_b32 s62, s62, 2
  s_add_u32 s61, s61, s62
  v_lshrrev_b32 v13, 2, v4
  v_lshl_add_u32 v13, v12, 3, v13
  v_add_u32 v13, s61, v13
  v_add_u32 v1, s32, v13
  v_and_b32 v1, 31, v1
  v_lshlrev_b32 v1, 7, v1
  v_lshl_add_u32 v95, v13, 12, v1
  v_and_b32 v13, 3, v2
  v_lshl_add_u32 v95, v13, 5, v95
  v_and_b32 v13, 1, v3
  v_lshl_add_u32 v95, v13, 4, v95
  s_lshl_b32 s61, s31, 17
  s_add_u32 s70, s61, 262144
  v_mov_b32 v5, 0x3ff
  s_lshr_b32 s61, s32, 4
  s_lshl_b32 s61, s61, 7
  s_lshl_b32 s62, s31, 4
  s_add_u32 s61, s61, s62
  s_and_b32 s62, s32, 15
  s_add_u32 s61, s61, s62
  s_and_b32 s62, s61, 3
  s_lshr_b32 s61, s61, 2
  s_lshl_b32 s61, s61, 14
  s_mul_i32 s62, s62, 1920
  s_add_u32 s61, s61, s62
  s_lshl_b32 s62, s33, 9
  s_add_u32 s61, s61, s62
  s_add_u32 s71, s61, 2097152
  v_lshlrev_b32 v6, 5, v4
  v_lshl_add_u32 v6, v13, 4, v6
  v_lshlrev_b32 v7, 4, v2
  s_barrier
  s_xor_b32 s57, s34, 0
  buffer_load_dwordx4 v[96:99], v14, s[36:39], s57 offen offset:0 nt
  buffer_load_dwordx4 v[100:103], v14, s[36:39], s57 offen offset:256 nt
  s_xor_b32 s57, s34, 8192
  buffer_load_dwordx4 v[104:107], v14, s[36:39], s57 offen offset:0 nt
  buffer_load_dwordx4 v[108:111], v14, s[36:39], s57 offen offset:256 nt
  s_xor_b32 s57, s34, 16384
  buffer_load_dwordx4 v[112:115], v14, s[36:39], s57 offen offset:0 nt
  buffer_load_dwordx4 v[116:119], v14, s[36:39], s57 offen offset:256 nt
  s_waitcnt vmcnt(5)
  s_xor_b32 s57, s34, 24576
  buffer_load_dwordx4 v[120:123], v14, s[36:39], s57 offen offset:0 nt
  s_waitcnt vmcnt(5)
  buffer_load_dwordx4 v[124:127], v14, s[36:39], s57 offen offset:256 nt
  s_waitcnt vmcnt(5)
  s_xor_b32 s57, s34, 32768
  buffer_load_dwordx4 v[128:131], v14, s[36:39], s57 offen offset:0 nt
  s_waitcnt vmcnt(5)
  buffer_load_dwordx4 v[132:135], v14, s[36:39], s57 offen offset:256 nt
  s_waitcnt vmcnt(5)
  s_xor_b32 s57, s34, 40960
  buffer_load_dwordx4 v[136:139], v14, s[36:39], s57 offen offset:0 nt
  s_waitcnt vmcnt(5)
  buffer_load_dwordx4 v[140:143], v14, s[36:39], s57 offen offset:256 nt
  s_waitcnt vmcnt(5)
  s_xor_b32 s57, s34, 49152
  buffer_load_dwordx4 v[144:147], v14, s[36:39], s57 offen offset:0 nt
  s_waitcnt vmcnt(5)
  buffer_load_dwordx4 v[148:151], v14, s[36:39], s57 offen offset:256 nt
  s_waitcnt vmcnt(5)
  s_xor_b32 s57, s34, 57344
  buffer_load_dwordx4 v[152:155], v14, s[36:39], s57 offen offset:0 nt
  s_waitcnt vmcnt(5)
  buffer_load_dwordx4 v[156:159], v14, s[36:39], s57 offen offset:256 nt
  s_waitcnt vmcnt(5)
  s_xor_b32 s57, s34, 65536
  buffer_load_dwordx4 v[160:163], v14, s[36:39], s57 offen offset:0 nt
  s_waitcnt vmcnt(5)
  buffer_load_dwordx4 v[164:167], v14, s[36:39], s57 offen offset:256 nt
  s_waitcnt vmcnt(5)
  s_xor_b32 s57, s34, 73728
  buffer_load_dwordx4 v[168:171], v14, s[36:39], s57 offen offset:0 nt
  s_waitcnt vmcnt(5)
  buffer_load_dwordx4 v[172:175], v14, s[36:39], s57 offen offset:256 nt
  s_waitcnt vmcnt(5)
  s_xor_b32 s57, s34, 81920
  buffer_load_dwordx4 v[176:179], v14, s[36:39], s57 offen offset:0 nt
  s_waitcnt vmcnt(5)
  buffer_load_dwordx4 v[180:183], v14, s[36:39], s57 offen offset:256 nt
  s_waitcnt vmcnt(5)
  s_xor_b32 s57, s34, 90112
  buffer_load_dwordx4 v[184:187], v14, s[36:39], s57 offen offset:0 nt
  s_waitcnt vmcnt(5)
  buffer_load_dwordx4 v[188:191], v14, s[36:39], s57 offen offset:256 nt
  s_lshl_b32 s61, s33, 2
  s_add_u32 s61, s61, 22600
  v_mov_b32 v12, s61
  s_mov_b32 s59, 2000000
L_pwait:
  ds_read_b32 v13, v12
  s_waitcnt lgkmcnt(0)
  v_readfirstlane_b32 s69, v13
  s_sub_u32 s59, s59, 1
  s_cbranch_scc1 L_pwait_done
  s_cmp_eq_u32 s69, 0
  s_cbranch_scc1 L_pwait
L_pwait_done:
  v_bfe_u32 v12, v2, 3, 1
  v_lshl_add_u32 v12, v12, 2, v3
  s_lshl_b32 s61, s33, 10
  s_add_u32 s61, s61, 16384
  v_lshl_add_u32 v13, v12, 6, s61
  v_lshl_add_u32 v12, v12, 4, s61
  ds_read_b128 v[48:51], v13 offset:0
  ds_read_b128 v[52:55], v13 offset:16
  ds_read_b128 v[56:59], v13 offset:32
  ds_read_b128 v[60:63], v13 offset:48
  ds_read_b128 v[64:67], v12 offset:512
  s_waitcnt lgkmcnt(0)
  v_and_b32 v68, v48, v8
  v_and_b32 v69, v48, v9
  v_and_b32 v70, v48, v10
  v_and_b32 v71, v48, v11
  s_waitcnt vmcnt(22)
  s_nop 0
  v_mfma_f32_16x16x32_bf16 v[76:79], v[68:71], v[96:99], 0
  v_mfma_f32_16x16x32_bf16 v[80:83], v[68:71], v[100:103], 0
  s_waitcnt vmcnt(5)
  s_xor_b32 s57, s34, 98304
  buffer_load_dwordx4 v[192:195], v14, s[36:39], s57 offen offset:0 nt
  v_and_b32 v72, v56, v8
  v_and_b32 v73, v56, v9
  v_and_b32 v74, v56, v10
  v_and_b32 v75, v56, v11
  s_waitcnt vmcnt(21)
  s_nop 0
  v_mfma_f32_16x16x32_bf16 v[76:79], v[72:75], v[104:107], v[76:79]
  v_mfma_f32_16x16x32_bf16 v[80:83], v[72:75], v[108:111], v[80:83]
  s_waitcnt vmcnt(5)
  buffer_load_dwordx4 v[196:199], v14, s[36:39], s57 offen offset:256 nt
  v_and_b32 v68, v49, v8
  v_and_b32 v69, v49, v9
  v_and_b32 v70, v49, v10
  v_and_b32 v71, v49, v11
  s_waitcnt vmcnt(20)
  s_nop 0
  v_mfma_f32_16x16x32_bf16 v[76:79], v[68:71], v[112:115], v[76:79]
  v_mfma_f32_16x16x32_bf16 v[80:83], v[68:71], v[116:119], v[80:83]
  s_waitcnt vmcnt(5)
  s_xor_b32 s57, s34, 106496
  buffer_load_dwordx4 v[200:203], v14, s[36:39], s57 offen offset:0 nt
  v_and_b32 v72, v57, v8
  v_and_b32 v73, v57, v9
  v_and_b32 v74, v57, v10
  v_and_b32 v75, v57, v11
  s_waitcnt vmcnt(19)
  s_nop 0
  v_mfma_f32_16x16x32_bf16 v[76:79], v[72:75], v[120:123], v[76:79]
  v_mfma_f32_16x16x32_bf16 v[80:83], v[72:75], v[124:127], v[80:83]
  s_waitcnt vmcnt(5)
  buffer_load_dwordx4 v[204:207], v14, s[36:39], s57 offen offset:256 nt
  v_and_b32 v68, v50, v8
  v_and_b32 v69, v50, v9
  v_and_b32 v70, v50, v10
  v_and_b32 v71, v50, v11
  s_waitcnt vmcnt(18)
  s_nop 0
  v_mfma_f32_16x16x32_bf16 v[76:79], v[68:71], v[128:131], v[76:79]
  v_mfma_f32_16x16x32_bf16 v[80:83], v[68:71], v[132:135], v[80:83]
  s_waitcnt vmcnt(5)
  s_xor_b32 s57, s34, 114688
  buffer_load_dwordx4 v[208:211], v14, s[36:39], s57 offen offset:0 nt
  v_and_b32 v72, v58, v8
  v_and_b32 v73, v58, v9
  v_and_b32 v74, v58, v10
  v_and_b32 v75, v58, v11
  s_waitcnt vmcnt(17)
  s_nop 0
  v_mfma_f32_16x16x32_bf16 v[76:79], v[72:75], v[136:139], v[76:79]
  v_mfma_f32_16x16x32_bf16 v[80:83], v[72:75], v[140:143], v[80:83]
  s_waitcnt vmcnt(5)
  buffer_load_dwordx4 v[212:215], v14, s[36:39], s57 offen offset:256 nt
  s_lshl_b32 s61, s33, 2
  s_add_u32 s61, s61, 22624
  v_mov_b32 v12, s61
  ds_write_b32 v12, v12
  v_and_b32 v68, v51, v8
  v_and_b32 v69, v51, v9
  v_and_b32 v70, v51, v10
  v_and_b32 v71, v51, v11
  s_waitcnt vmcnt(16)
  s_nop 0
  v_mfma_f32_16x16x32_bf16 v[76:79], v[68:71], v[144:147], v[76:79]
  v_mfma_f32_16x16x32_bf16 v[80:83], v[68:71], v[148:151], v[80:83]
  s_waitcnt vmcnt(5)
  s_xor_b32 s57, s34, 122880
  buffer_load_dwordx4 v[216:219], v14, s[36:39], s57 offen offset:0 nt
  v_and_b32 v72, v59, v8
  v_and_b32 v73, v59, v9
  v_and_b32 v74, v59, v10
  v_and_b32 v75, v59, v11
  s_waitcnt vmcnt(15)
  s_nop 0
  v_mfma_f32_16x16x32_bf16 v[76:79], v[72:75], v[152:155], v[76:79]
  v_mfma_f32_16x16x32_bf16 v[80:83], v[72:75], v[156:159], v[80:83]
  s_waitcnt vmcnt(5)
  buffer_load_dwordx4 v[220:223], v14, s[36:39], s57 offen offset:256 nt
  v_and_b32 v68, v52, v8
  v_and_b32 v69, v52, v9
  v_and_b32 v70, v52, v10
  v_and_b32 v71, v52, v11
  s_waitcnt vmcnt(14)
  s_nop 0
  v_mfma_f32_16x16x32_bf16 v[76:79], v[68:71], v[160:163], v[76:79]
  v_mfma_f32_16x16x32_bf16 v[80:83], v[68:71], v[164:167], v[80:83]
  s_waitcnt vmcnt(5)
  buffer_load_dwordx4 v[16:19], v15, s[44:47], s48 offen offset:0 nt
  v_and_b32 v72, v60, v8
  v_and_b32 v73, v60, v9
  v_and_b32 v74, v60, v10
  v_and_b32 v75, v60, v11
  s_waitcnt vmcnt(13)
  s_nop 0
  v_mfma_f32_16x16x32_bf16 v[76:79], v[72:75], v[168:171], v[76:79]
  v_mfma_f32_16x16x32_bf16 v[80:83], v[72:75], v[172:175], v[80:83]
  s_waitcnt vmcnt(5)
  s_xor_b32 s57, s35, 0
  buffer_load_dwordx4 v[224:227], v14, s[40:43], s57 offen offset:0 nt
  v_and_b32 v68, v53, v8
  v_and_b32 v69, v53, v9
  v_and_b32 v70, v53, v10
  v_and_b32 v71, v53, v11
  s_waitcnt vmcnt(12)
  s_nop 0
  v_mfma_f32_16x16x32_bf16 v[76:79], v[68:71], v[176:179], v[76:79]
  v_mfma_f32_16x16x32_bf16 v[80:83], v[68:71], v[180:183], v[80:83]
  s_waitcnt vmcnt(5)
  buffer_load_dwordx4 v[228:231], v14, s[40:43], s57 offen offset:256 nt
  v_and_b32 v72, v61, v8
  v_and_b32 v73, v61, v9
  v_and_b32 v74, v61, v10
  v_and_b32 v75, v61, v11
  s_waitcnt vmcnt(11)
  s_nop 0
  v_mfma_f32_16x16x32_bf16 v[76:79], v[72:75], v[184:187], v[76:79]
  v_mfma_f32_16x16x32_bf16 v[80:83], v[72:75], v[188:191], v[80:83]
  s_waitcnt vmcnt(5)
  s_xor_b32 s57, s35, 8192
  buffer_load_dwordx4 v[232:235], v14, s[40:43], s57 offen offset:0 nt
  v_and_b32 v68, v54, v8
  v_and_b32 v69, v54, v9
  v_and_b32 v70, v54, v10
  v_and_b32 v71, v54, v11
  s_waitcnt vmcnt(10)
  s_nop 0
  v_mfma_f32_16x16x32_bf16 v[76:79], v[68:71], v[192:195], v[76:79]
  v_mfma_f32_16x16x32_bf16 v[80:83], v[68:71], v[196:199], v[80:83]
  s_waitcnt vmcnt(5)
  buffer_load_dwordx4 v[236:239], v14, s[40:43], s57 offen offset:256 nt
  v_and_b32 v72, v62, v8
  v_and_b32 v73, v62, v9
  v_and_b32 v74, v62, v10
  v_and_b32 v75, v62, v11
  s_waitcnt vmcnt(9)
  s_nop 0
  v_mfma_f32_16x16x32_bf16 v[76:79], v[72:75], v[200:203], v[76:79]
  v_mfma_f32_16x16x32_bf16 v[80:83], v[72:75], v[204:207], v[80:83]
  s_waitcnt vmcnt(5)
  s_xor_b32 s57, s35, 16384
  buffer_load_dwordx4 v[240:243], v14, s[40:43], s57 offen offset:0 nt
  v_and_b32 v68, v55, v8
  v_and_b32 v69, v55, v9
  v_and_b32 v70, v55, v10
  v_and_b32 v71, v55, v11
  s_waitcnt vmcnt(8)
  s_nop 0
  v_mfma_f32_16x16x32_bf16 v[76:79], v[68:71], v[208:211], v[76:79]
  v_mfma_f32_16x16x32_bf16 v[80:83], v[68:71], v[212:215], v[80:83]
  s_waitcnt vmcnt(5)
  buffer_load_dwordx4 v[244:247], v14, s[40:43], s57 offen offset:256 nt
  v_and_b32 v72, v63, v8
  v_and_b32 v73, v63, v9
  v_and_b32 v74, v63, v10
  v_and_b32 v75, v63, v11
  s_waitcnt vmcnt(7)
  s_nop 0
  v_mfma_f32_16x16x32_bf16 v[76:79], v[72:75], v[216:219], v[76:79]
  v_mfma_f32_16x16x32_bf16 v[80:83], v[72:75], v[220:223], v[80:83]
  s_waitcnt vmcnt(5)
  s_xor_b32 s57, s35, 24576
  buffer_load_dwordx4 v[248:251], v14, s[40:43], s57 offen offset:0 nt
  s_waitcnt vmcnt(5)
  buffer_load_dwordx4 v[252:255], v14, s[40:43], s57 offen offset:256 nt
  v_and_b32 v68, v64, v8
  v_and_b32 v69, v64, v9
  v_and_b32 v70, v64, v10
  v_and_b32 v71, v64, v11
  s_waitcnt vmcnt(6)
  s_nop 0
  v_mfma_f32_16x16x32_bf16 v[84:87], v[68:71], v[224:227], 0
  v_mfma_f32_16x16x32_bf16 v[88:91], v[68:71], v[228:231], 0
  s_waitcnt vmcnt(5)
  buffer_load_dwordx4 v[20:23], v15, s[44:47], s48 offen offset:896 nt
  s_waitcnt vmcnt(5)
  buffer_load_dwordx4 v[24:27], v15, s[44:47], s48 offen offset:1792 nt
  v_and_b32 v72, v66, v8
  v_and_b32 v73, v66, v9
  v_and_b32 v74, v66, v10
  v_and_b32 v75, v66, v11
  s_waitcnt vmcnt(6)
  s_nop 0
  v_mfma_f32_16x16x32_bf16 v[84:87], v[72:75], v[232:235], v[84:87]
  v_mfma_f32_16x16x32_bf16 v[88:91], v[72:75], v[236:239], v[88:91]
  ds_write_b128 v92, v[76:79] offset:0
  ds_write_b128 v92, v[80:83] offset:1024
  s_waitcnt vmcnt(5)
  buffer_load_dwordx4 v[28:31], v15, s[44:47], s48 offen offset:2688 nt
  s_waitcnt vmcnt(5)
  buffer_load_dwordx4 v[32:35], v15, s[44:47], s49 offen offset:0 nt
  v_and_b32 v68, v65, v8
  v_and_b32 v69, v65, v9
  v_and_b32 v70, v65, v10
  v_and_b32 v71, v65, v11
  s_waitcnt vmcnt(6)
  s_nop 0
  v_mfma_f32_16x16x32_bf16 v[84:87], v[68:71], v[240:243], v[84:87]
  v_mfma_f32_16x16x32_bf16 v[88:91], v[68:71], v[244:247], v[88:91]
  s_waitcnt vmcnt(5)
  buffer_load_dwordx4 v[36:39], v15, s[44:47], s49 offen offset:896 nt
  s_waitcnt vmcnt(5)
  buffer_load_dwordx4 v[40:43], v15, s[44:47], s49 offen offset:1792 nt
  v_and_b32 v72, v67, v8
  v_and_b32 v73, v67, v9
  v_and_b32 v74, v67, v10
  v_and_b32 v75, v67, v11
  s_waitcnt vmcnt(6)
  s_nop 0
  v_mfma_f32_16x16x32_bf16 v[84:87], v[72:75], v[248:251], v[84:87]
  v_mfma_f32_16x16x32_bf16 v[88:91], v[72:75], v[252:255], v[88:91]
  s_waitcnt vmcnt(5)
  buffer_load_dwordx4 v[44:47], v15, s[44:47], s49 offen offset:2688 nt
  s_nop 6
  ds_write_b128 v92, v[84:87] offset:2048
  ds_write_b128 v92, v[88:91] offset:3072
  s_waitcnt lgkmcnt(0)
  s_barrier
  ds_read_b32 v13, v7 offset:22620
  ds_read_b128 v[112:115], v94
  ds_read_b128 v[96:99], v93 offset:0
  ds_read_b128 v[100:103], v93 offset:4096
  ds_read_b128 v[104:107], v93 offset:8192
  ds_read_b128 v[108:111], v93 offset:12288
  s_waitcnt lgkmcnt(3)
  v_readfirstlane_b32 s61, v13
  v_pk_mul_f32 v[116:117], v[96:97], v[112:113] op_sel:[0,0] op_sel_hi:[1,0]
  v_pk_mul_f32 v[118:119], v[98:99], v[112:113] op_sel:[0,0] op_sel_hi:[1,0]
  s_waitcnt lgkmcnt(2)
  s_cmp_eq_u32 s61, 0
  v_pk_fma_f32 v[116:117], v[100:101], v[112:113], v[116:117] op_sel:[0,1,0] op_sel_hi:[1,1,1]
  v_pk_fma_f32 v[118:119], v[102:103], v[112:113], v[118:119] op_sel:[0,1,0] op_sel_hi:[1,1,1]
  s_waitcnt lgkmcnt(1)
  v_pk_fma_f32 v[116:117], v[104:105], v[114:115], v[116:117] op_sel:[0,0,0] op_sel_hi:[1,0,1]
  v_pk_fma_f32 v[118:119], v[106:107], v[114:115], v[118:119] op_sel:[0,0,0] op_sel_hi:[1,0,1]
  s_waitcnt lgkmcnt(0)
  v_pk_fma_f32 v[116:117], v[108:109], v[114:115], v[116:117] op_sel:[0,1,0] op_sel_hi:[1,1,1]
  v_pk_fma_f32 v[118:119], v[110:111], v[114:115], v[118:119] op_sel:[0,1,0] op_sel_hi:[1,1,1]
  v_bfi_b32 v116, v5, s64, v116
  v_bfi_b32 v117, v5, s65, v117
  v_bfi_b32 v118, v5, s66, v118
  v_bfi_b32 v119, v5, s67, v119
  s_cbranch_scc0 L_x3slow
  buffer_store_dwordx4 v[116:119], v95, s[52:55], s70 offen
L_x3done:
  s_waitcnt vmcnt(1)
  s_barrier
  ds_read_b128 v[128:131], v7 offset:24576
  ds_read_b128 v[132:135], v7 offset:25600
  ds_read_b128 v[136:139], v7 offset:26624
  ds_read_b128 v[140:143], v7 offset:27648
  ds_read_b128 v[144:147], v7 offset:28672
  ds_read_b128 v[148:151], v7 offset:29696
  ds_read_b128 v[152:155], v7 offset:30720
  ds_read_b128 v[156:159], v7 offset:31744
  s_waitcnt lgkmcnt(7)
  v_mfma_f32_16x16x32_bf16 v[96:99], v[128:131], v[16:19], 0
  s_waitcnt lgkmcnt(6)
  v_mfma_f32_16x16x32_bf16 v[96:99], v[132:135], v[20:23], v[96:99]
  s_waitcnt lgkmcnt(5)
  v_mfma_f32_16x16x32_bf16 v[96:99], v[136:139], v[24:27], v[96:99]
  s_waitcnt lgkmcnt(4)
  v_mfma_f32_16x16x32_bf16 v[96:99], v[140:143], v[28:31], v[96:99]
  s_waitcnt lgkmcnt(3)
  v_mfma_f32_16x16x32_bf16 v[96:99], v[144:147], v[32:35], v[96:99]
  s_waitcnt lgkmcnt(2)
  v_mfma_f32_16x16x32_bf16 v[96:99], v[148:151], v[36:39], v[96:99]
  s_waitcnt lgkmcnt(1)
  v_mfma_f32_16x16x32_bf16 v[96:99], v[152:155], v[40:43], v[96:99]
  s_waitcnt lgkmcnt(0)
  v_mfma_f32_16x16x32_bf16 v[96:99], v[156:159], v[44:47], v[96:99]
  s_mov_b32 exec_lo, s58
  s_mov_b32 exec_hi, 0
  s_nop 5
  v_bfi_b32 v100, v5, s64, v96
  v_bfi_b32 v101, v5, s65, v97
  v_bfi_b32 v102, v5, s66, v98
  v_bfi_b32 v103, v5, s67, v99
  buffer_store_dwordx4 v[100:103], v6, s[52:55], s71 offen sc1
L_fin:
L_end:
  s_endpgm
L_x3slow:
  buffer_store_dwordx4 v[116:119], v95, s[52:55], s70 offen sc1
  s_branch L_x3done
.section .rodata,"a"
.p2align 6
.amdhsa_kernel concat_heads__gqa_block_cached__sliding_block_cached__decode_kernel
  .amdhsa_next_free_vgpr 256
  .amdhsa_next_free_sgpr 96
  .amdhsa_accum_offset 256
  .amdhsa_group_segment_fixed_size 0
  .amdhsa_kernarg_size 104
  .amdhsa_user_sgpr_count 2
  .amdhsa_user_sgpr_kernarg_segment_ptr 1
  .amdhsa_system_sgpr_workgroup_id_x 1
.end_amdhsa_kernel
```
